```python
import torch

def _softmax(x, axis=-1):
    return torch.softmax(x, dim=axis)
def _gelu(x):
    return torch.nn.functional.gelu(x, approximate="tanh")
def _silu(x):
    return torch.nn.functional.silu(x)
def _sigmoid(x):
    return torch.sigmoid(x)
def _layernorm(x, axis=-1, eps=1e-5):
    m = x.mean(dim=axis, keepdim=True)
    v = x.var(dim=axis, keepdim=True, unbiased=False)
    return (x - m) / torch.sqrt(v + eps)
def _scatter_add(tgt, idx, src, axis=0):
    return tgt.clone().index_add_(axis, idx, src)
def _segment_sum(src, seg, n):
    out = torch.zeros((n,) + src.shape[1:], dtype=src.dtype)
    return out.index_add_(0, seg, src)
def _pad(x, pw):
    flat = tuple(v for pair in reversed(pw) for v in pair)
    return torch.nn.functional.pad(x, flat)

kernel_name = 'standalone__low_rank_proj_linformer__sampling'

def setup_inputs():

    _w = (lambda a: (lambda t: t.to(torch.bfloat16) if t.is_floating_point() else t)(torch.as_tensor(a)))
    B, H, Sq, Skv, Dh, R = 8, 32, 8, 4096, 128, 16
    return {
        "q": _w((lambda *s: torch.randn(*s, dtype=torch.bfloat16) * 0.8)(B, H, Sq, Dh)),
        "k": _w((lambda *s: torch.randn(*s, dtype=torch.bfloat16) * 0.8)(B, H, Skv, Dh)),
        "v": _w((lambda *s: torch.randn(*s, dtype=torch.bfloat16) * 0.05)(B, H, Skv, Dh)),
        "e_proj": _w((lambda *s: torch.randn(*s, dtype=torch.bfloat16) * 0.8)(R, Skv) * (Skv ** -0.5)),
        "f_proj": _w((lambda *s: torch.randn(*s, dtype=torch.bfloat16) * 0.05)(R, Skv) * (Skv ** -0.5)),
    }

def reference(q, k, v, e_proj, f_proj):
    B, H, Sq, Dh = q.shape
    kp = torch.einsum("rn,bhnd->bhrd", e_proj, k)
    vp = torch.einsum("rn,bhnd->bhrd", f_proj, v)
    scores = torch.einsum("bhqd,bhrd->bhqr", q, kp) * (Dh ** -0.5)
    p = _softmax(scores, axis=-1)
    o = torch.einsum("bhqr,bhrd->bhqd", p, vp)
    return o
```

```asm
; @launch grid=(256,1,1) block=(128,1,1) lds=90000
.amdgcn_target "amdgcn-amd-amdhsa--gfx950"
.text
.globl standalone__low_rank_proj_linformer__sampling_kernel
.p2align 8
.type standalone__low_rank_proj_linformer__sampling_kernel,@function
standalone__low_rank_proj_linformer__sampling_kernel:
    s_load_dwordx16 s[4:19], s[0:1], 0
    s_cmp_ge_u32 s2, 256
    s_cbranch_scc1 L_end
    v_readfirstlane_b32 s36, v0
    v_and_b32 v0, 63, v0
    v_lshrrev_b32 v6, 4, v0
    v_and_b32 v7, 15, v0
    s_lshl_b32 s43, s2, 20
    s_mov_b32 s27, 0x20000
    s_cmp_eq_u32 s36, 0
    s_cbranch_scc1 L_stream
    s_getpc_b64 s[58:59]
L_pc:
    s_lshr_b32 s62, s2, 3
    s_mul_i32 s63, s62, 11
    s_lshr_b32 s63, s63, 5
    s_lshl_b32 s63, s63, 10
    v_lshl_add_u32 v8, v0, 4, s63
    global_load_dwordx4 v[12:15], v8, s[58:59]
    s_branch L_helper
L_stream:
    v_and_b32 v3, 1, v6
    v_lshrrev_b32 v4, 1, v6
    v_lshlrev_b32 v1, 13, v3
    v_lshl_add_u32 v1, v4, 16, v1
    v_lshrrev_b32 v2, 7, v1
    v_lshl_add_u32 v1, v7, 4, v1
    v_lshl_add_u32 v2, v7, 13, v2
    s_mov_b32 s22, 0x200000
    s_mov_b32 s23, 0x20000
    s_mov_b32 s26, 0x20000
    s_mov_b32 s57, 0
    s_brev_b32 s56, s2
    s_lshr_b32 s58, s56, 13
    s_and_b32 s58, s58, 0x8000
    s_lshr_b32 s56, s56, 12
    s_and_b32 s56, s56, 0xe0000
    s_or_b32 s56, s56, s58
    s_mov_b32 s39, s56
    s_waitcnt lgkmcnt(0)
    s_add_u32 s20, s6, s43
    s_addc_u32 s21, s7, 0
    s_mov_b64 s[24:25], s[10:11]
    buffer_load_dwordx4 v[72:75], v1, s[20:23], s39 offen nt
    buffer_load_dwordx4 v[76:79], v1, s[20:23], s39 offen offset:256 nt
    buffer_load_dwordx4 v[80:83], v1, s[20:23], s39 offen offset:512 nt
    buffer_load_dwordx4 v[84:87], v1, s[20:23], s39 offen offset:768 nt
    buffer_load_dwordx4 v[88:91], v1, s[20:23], s39 offen offset:1024 nt
    buffer_load_dwordx4 v[92:95], v1, s[20:23], s39 offen offset:1280 nt
    s_bfe_u32 s40, s39, 0xd0007
    buffer_load_dwordx4 v[200:203], v2, s[24:27], s40 offen
    buffer_load_dwordx4 v[96:99], v1, s[20:23], s39 offen offset:1536 nt
    buffer_load_dwordx4 v[100:103], v1, s[20:23], s39 offen offset:1792 nt
    s_xor_b32 s39, s39, 0x800
    buffer_load_dwordx4 v[104:107], v1, s[20:23], s39 offen nt
    buffer_load_dwordx4 v[108:111], v1, s[20:23], s39 offen offset:256 nt
    buffer_load_dwordx4 v[112:115], v1, s[20:23], s39 offen offset:512 nt
    buffer_load_dwordx4 v[116:119], v1, s[20:23], s39 offen offset:768 nt
    buffer_load_dwordx4 v[120:123], v1, s[20:23], s39 offen offset:1024 nt
    buffer_load_dwordx4 v[124:127], v1, s[20:23], s39 offen offset:1280 nt
    s_bfe_u32 s40, s39, 0xd0007
    buffer_load_dwordx4 v[204:207], v2, s[24:27], s40 offen
    buffer_load_dwordx4 v[128:131], v1, s[20:23], s39 offen offset:1536 nt
    buffer_load_dwordx4 v[132:135], v1, s[20:23], s39 offen offset:1792 nt
    s_xor_b32 s39, s39, 0x1800
    buffer_load_dwordx4 v[136:139], v1, s[20:23], s39 offen nt
    buffer_load_dwordx4 v[140:143], v1, s[20:23], s39 offen offset:256 nt
    buffer_load_dwordx4 v[144:147], v1, s[20:23], s39 offen offset:512 nt
    buffer_load_dwordx4 v[148:151], v1, s[20:23], s39 offen offset:768 nt
    buffer_load_dwordx4 v[152:155], v1, s[20:23], s39 offen offset:1024 nt
    buffer_load_dwordx4 v[156:159], v1, s[20:23], s39 offen offset:1280 nt
    s_bfe_u32 s40, s39, 0xd0007
    buffer_load_dwordx4 v[208:211], v2, s[24:27], s40 offen
    buffer_load_dwordx4 v[160:163], v1, s[20:23], s39 offen offset:1536 nt
    buffer_load_dwordx4 v[164:167], v1, s[20:23], s39 offen offset:1792 nt
    s_mov_b32 s37, 0x05040100
    s_mov_b32 s38, 0x07060302
    s_add_u32 s44, s8, s43
    s_addc_u32 s45, s9, 0
    s_sub_u32 s44, s44, 0x100000
    s_subb_u32 s45, s45, 0
    s_lshl_b32 s48, s2, 11
    s_add_u32 s32, s14, s48
    s_addc_u32 s33, s15, 0
    s_mov_b32 s35, 0x20000
    s_mov_b32 s34, 2048
    s_mov_b32 s52, 0xaaaaaa80
    s_mov_b32 s53, 0x2aaaaaaa
    s_mov_b32 s54, 0x0
    s_mov_b32 s55, 0x80000001
    s_mov_b32 s50, 0
    s_mov_b32 s51, 128
    v_lshlrev_b32 v3, 4, v0
    v_lshlrev_b32 v4, 3, v0
    v_lshlrev_b32 v5, 10, v6
    v_lshl_add_u32 v5, v7, 4, v5
    v_mov_b32 v216, 0
    v_mov_b32 v217, 512
    ds_write_b32 v216, v217 offset:8704
    v_pk_mov_b32 v[40:41], 0, 0
    v_pk_mov_b32 v[42:43], 0, 0
    v_pk_mov_b32 v[44:45], 0, 0
    v_pk_mov_b32 v[46:47], 0, 0
    v_pk_mov_b32 v[48:49], 0, 0
    v_pk_mov_b32 v[50:51], 0, 0
    v_pk_mov_b32 v[52:53], 0, 0
    v_pk_mov_b32 v[54:55], 0, 0
    v_pk_mov_b32 v[56:57], 0, 0
    v_pk_mov_b32 v[58:59], 0, 0
    v_pk_mov_b32 v[60:61], 0, 0
    v_pk_mov_b32 v[62:63], 0, 0
    v_pk_mov_b32 v[64:65], 0, 0
    v_pk_mov_b32 v[66:67], 0, 0
    v_pk_mov_b32 v[68:69], 0, 0
    v_pk_mov_b32 v[70:71], 0, 0
L_body_11:
    s_waitcnt vmcnt(23)
    s_xor_b32 s39, s39, 0x800
    buffer_load_dwordx4 v[168:171], v1, s[20:23], s39 offen nt
    buffer_load_dwordx4 v[172:175], v1, s[20:23], s39 offen offset:256 nt
    v_perm_b32 v8, v76, v72, s37
    v_perm_b32 v12, v76, v72, s38
    v_perm_b32 v16, v77, v73, s37
    v_perm_b32 v20, v77, v73, s38
    v_perm_b32 v24, v78, v74, s37
    v_perm_b32 v28, v78, v74, s38
    v_perm_b32 v32, v79, v75, s37
    v_perm_b32 v36, v79, v75, s38
    s_waitcnt vmcnt(23)
    buffer_load_dwordx4 v[176:179], v1, s[20:23], s39 offen offset:512 nt
    buffer_load_dwordx4 v[180:183], v1, s[20:23], s39 offen offset:768 nt
    v_perm_b32 v9, v84, v80, s37
    v_perm_b32 v13, v84, v80, s38
    v_perm_b32 v17, v85, v81, s37
    v_perm_b32 v21, v85, v81, s38
    v_perm_b32 v25, v86, v82, s37
    v_perm_b32 v29, v86, v82, s38
    v_perm_b32 v33, v87, v83, s37
    v_perm_b32 v37, v87, v83, s38
    s_waitcnt vmcnt(22)
    buffer_load_dwordx4 v[184:187], v1, s[20:23], s39 offen offset:1024 nt
    buffer_load_dwordx4 v[188:191], v1, s[20:23], s39 offen offset:1280 nt
    v_perm_b32 v10, v92, v88, s37
    v_perm_b32 v14, v92, v88, s38
    v_perm_b32 v18, v93, v89, s37
    v_perm_b32 v22, v93, v89, s38
    v_perm_b32 v26, v94, v90, s37
    v_perm_b32 v30, v94, v90, s38
    v_perm_b32 v34, v95, v91, s37
    v_perm_b32 v38, v95, v91, s38
    s_waitcnt vmcnt(22)
    s_bfe_u32 s40, s39, 0xd0007
    buffer_load_dwordx4 v[212:215], v2, s[24:27], s40 offen
    buffer_load_dwordx4 v[192:195], v1, s[20:23], s39 offen offset:1536 nt
    buffer_load_dwordx4 v[196:199], v1, s[20:23], s39 offen offset:1792 nt
    v_perm_b32 v11, v100, v96, s37
    v_perm_b32 v15, v100, v96, s38
    v_perm_b32 v19, v101, v97, s37
    v_perm_b32 v23, v101, v97, s38
    v_perm_b32 v27, v102, v98, s37
    v_perm_b32 v31, v102, v98, s38
    v_perm_b32 v35, v103, v99, s37
    v_perm_b32 v39, v103, v99, s38
    v_mfma_f32_16x16x32_bf16 v[40:43], v[200:203], v[8:11], v[40:43]
    v_mfma_f32_16x16x32_bf16 v[44:47], v[200:203], v[12:15], v[44:47]
    v_mfma_f32_16x16x32_bf16 v[48:51], v[200:203], v[16:19], v[48:51]
    v_mfma_f32_16x16x32_bf16 v[52:55], v[200:203], v[20:23], v[52:55]
    v_mfma_f32_16x16x32_bf16 v[56:59], v[200:203], v[24:27], v[56:59]
    v_mfma_f32_16x16x32_bf16 v[60:63], v[200:203], v[28:31], v[60:63]
    v_mfma_f32_16x16x32_bf16 v[64:67], v[200:203], v[32:35], v[64:67]
    v_mfma_f32_16x16x32_bf16 v[68:71], v[200:203], v[36:39], v[68:71]
    s_waitcnt vmcnt(23)
    s_or_b32 s57, s57, 0x13800
    s_add_u32 s57, s57, 0x800
    s_and_b32 s57, s57, 0xfffec7ff
    s_cmp_ge_u32 s57, 0x100000
    s_cselect_b64 s[20:21], s[44:45], s[20:21]
    s_cselect_b64 s[24:25], s[12:13], s[24:25]
    s_xor_b32 s39, s57, s56
    buffer_load_dwordx4 v[72:75], v1, s[20:23], s39 offen nt
    buffer_load_dwordx4 v[76:79], v1, s[20:23], s39 offen offset:256 nt
    v_perm_b32 v8, v108, v104, s37
    v_perm_b32 v12, v108, v104, s38
    v_perm_b32 v16, v109, v105, s37
    v_perm_b32 v20, v109, v105, s38
    v_perm_b32 v24, v110, v106, s37
    v_perm_b32 v28, v110, v106, s38
    v_perm_b32 v32, v111, v107, s37
    v_perm_b32 v36, v111, v107, s38
    s_waitcnt vmcnt(23)
    buffer_load_dwordx4 v[80:83], v1, s[20:23], s39 offen offset:512 nt
    buffer_load_dwordx4 v[84:87], v1, s[20:23], s39 offen offset:768 nt
    v_perm_b32 v9, v116, v112, s37
    v_perm_b32 v13, v116, v112, s38
    v_perm_b32 v17, v117, v113, s37
    v_perm_b32 v21, v117, v113, s38
    v_perm_b32 v25, v118, v114, s37
    v_perm_b32 v29, v118, v114, s38
    v_perm_b32 v33, v119, v115, s37
    v_perm_b32 v37, v119, v115, s38
    s_waitcnt vmcnt(22)
    buffer_load_dwordx4 v[88:91], v1, s[20:23], s39 offen offset:1024 nt
    buffer_load_dwordx4 v[92:95], v1, s[20:23], s39 offen offset:1280 nt
    v_perm_b32 v10, v124, v120, s37
    v_perm_b32 v14, v124, v120, s38
    v_perm_b32 v18, v125, v121, s37
    v_perm_b32 v22, v125, v121, s38
    v_perm_b32 v26, v126, v122, s37
    v_perm_b32 v30, v126, v122, s38
    v_perm_b32 v34, v127, v123, s37
    v_perm_b32 v38, v127, v123, s38
    s_waitcnt vmcnt(22)
    s_bfe_u32 s40, s39, 0xd0007
    buffer_load_dwordx4 v[200:203], v2, s[24:27], s40 offen
    buffer_load_dwordx4 v[96:99], v1, s[20:23], s39 offen offset:1536 nt
    buffer_load_dwordx4 v[100:103], v1, s[20:23], s39 offen offset:1792 nt
    v_perm_b32 v11, v132, v128, s37
    v_perm_b32 v15, v132, v128, s38
    v_perm_b32 v19, v133, v129, s37
    v_perm_b32 v23, v133, v129, s38
    v_perm_b32 v27, v134, v130, s37
    v_perm_b32 v31, v134, v130, s38
    v_perm_b32 v35, v135, v131, s37
    v_perm_b32 v39, v135, v131, s38
    v_mfma_f32_16x16x32_bf16 v[40:43], v[204:207], v[8:11], v[40:43]
    v_mfma_f32_16x16x32_bf16 v[44:47], v[204:207], v[12:15], v[44:47]
    v_mfma_f32_16x16x32_bf16 v[48:51], v[204:207], v[16:19], v[48:51]
    v_mfma_f32_16x16x32_bf16 v[52:55], v[204:207], v[20:23], v[52:55]
    v_mfma_f32_16x16x32_bf16 v[56:59], v[204:207], v[24:27], v[56:59]
    v_mfma_f32_16x16x32_bf16 v[60:63], v[204:207], v[28:31], v[60:63]
    v_mfma_f32_16x16x32_bf16 v[64:67], v[204:207], v[32:35], v[64:67]
    v_mfma_f32_16x16x32_bf16 v[68:71], v[204:207], v[36:39], v[68:71]
    s_waitcnt vmcnt(23)
    s_xor_b32 s39, s39, 0x800
    buffer_load_dwordx4 v[104:107], v1, s[20:23], s39 offen nt
    buffer_load_dwordx4 v[108:111], v1, s[20:23], s39 offen offset:256 nt
    v_perm_b32 v8, v140, v136, s37
    v_perm_b32 v12, v140, v136, s38
    v_perm_b32 v16, v141, v137, s37
    v_perm_b32 v20, v141, v137, s38
    v_perm_b32 v24, v142, v138, s37
    v_perm_b32 v28, v142, v138, s38
    v_perm_b32 v32, v143, v139, s37
    v_perm_b32 v36, v143, v139, s38
    s_waitcnt vmcnt(23)
    buffer_load_dwordx4 v[112:115], v1, s[20:23], s39 offen offset:512 nt
    buffer_load_dwordx4 v[116:119], v1, s[20:23], s39 offen offset:768 nt
    v_perm_b32 v9, v148, v144, s37
    v_perm_b32 v13, v148, v144, s38
    v_perm_b32 v17, v149, v145, s37
    v_perm_b32 v21, v149, v145, s38
    v_perm_b32 v25, v150, v146, s37
    v_perm_b32 v29, v150, v146, s38
    v_perm_b32 v33, v151, v147, s37
    v_perm_b32 v37, v151, v147, s38
    s_waitcnt vmcnt(22)
    buffer_load_dwordx4 v[120:123], v1, s[20:23], s39 offen offset:1024 nt
    buffer_load_dwordx4 v[124:127], v1, s[20:23], s39 offen offset:1280 nt
    v_perm_b32 v10, v156, v152, s37
    v_perm_b32 v14, v156, v152, s38
    v_perm_b32 v18, v157, v153, s37
    v_perm_b32 v22, v157, v153, s38
    v_perm_b32 v26, v158, v154, s37
    v_perm_b32 v30, v158, v154, s38
    v_perm_b32 v34, v159, v155, s37
    v_perm_b32 v38, v159, v155, s38
    s_waitcnt vmcnt(22)
    s_bfe_u32 s40, s39, 0xd0007
    buffer_load_dwordx4 v[204:207], v2, s[24:27], s40 offen
    buffer_load_dwordx4 v[128:131], v1, s[20:23], s39 offen offset:1536 nt
    buffer_load_dwordx4 v[132:135], v1, s[20:23], s39 offen offset:1792 nt
    v_perm_b32 v11, v164, v160, s37
    v_perm_b32 v15, v164, v160, s38
    v_perm_b32 v19, v165, v161, s37
    v_perm_b32 v23, v165, v161, s38
    v_perm_b32 v27, v166, v162, s37
    v_perm_b32 v31, v166, v162, s38
    v_perm_b32 v35, v167, v163, s37
    v_perm_b32 v39, v167, v163, s38
    v_mfma_f32_16x16x32_bf16 v[40:43], v[208:211], v[8:11], v[40:43]
    v_mfma_f32_16x16x32_bf16 v[44:47], v[208:211], v[12:15], v[44:47]
    v_mfma_f32_16x16x32_bf16 v[48:51], v[208:211], v[16:19], v[48:51]
    v_mfma_f32_16x16x32_bf16 v[52:55], v[208:211], v[20:23], v[52:55]
    v_mfma_f32_16x16x32_bf16 v[56:59], v[208:211], v[24:27], v[56:59]
    v_mfma_f32_16x16x32_bf16 v[60:63], v[208:211], v[28:31], v[60:63]
    v_mfma_f32_16x16x32_bf16 v[64:67], v[208:211], v[32:35], v[64:67]
    v_mfma_f32_16x16x32_bf16 v[68:71], v[208:211], v[36:39], v[68:71]
    s_waitcnt vmcnt(23)
    s_xor_b32 s39, s39, 0x1800
    buffer_load_dwordx4 v[136:139], v1, s[20:23], s39 offen nt
    buffer_load_dwordx4 v[140:143], v1, s[20:23], s39 offen offset:256 nt
    v_perm_b32 v8, v172, v168, s37
    v_perm_b32 v12, v172, v168, s38
    v_perm_b32 v16, v173, v169, s37
    v_perm_b32 v20, v173, v169, s38
    v_perm_b32 v24, v174, v170, s37
    v_perm_b32 v28, v174, v170, s38
    v_perm_b32 v32, v175, v171, s37
    v_perm_b32 v36, v175, v171, s38
    s_waitcnt vmcnt(23)
    buffer_load_dwordx4 v[144:147], v1, s[20:23], s39 offen offset:512 nt
    buffer_load_dwordx4 v[148:151], v1, s[20:23], s39 offen offset:768 nt
    v_perm_b32 v9, v180, v176, s37
    v_perm_b32 v13, v180, v176, s38
    v_perm_b32 v17, v181, v177, s37
    v_perm_b32 v21, v181, v177, s38
    v_perm_b32 v25, v182, v178, s37
    v_perm_b32 v29, v182, v178, s38
    v_perm_b32 v33, v183, v179, s37
    v_perm_b32 v37, v183, v179, s38
    ds_read_b32 v217, v216 offset:8704
    s_waitcnt vmcnt(22)
    buffer_load_dwordx4 v[152:155], v1, s[20:23], s39 offen offset:1024 nt
    buffer_load_dwordx4 v[156:159], v1, s[20:23], s39 offen offset:1280 nt
    v_perm_b32 v10, v188, v184, s37
    v_perm_b32 v14, v188, v184, s38
    v_perm_b32 v18, v189, v185, s37
    v_perm_b32 v22, v189, v185, s38
    v_perm_b32 v26, v190, v186, s37
    v_perm_b32 v30, v190, v186, s38
    v_perm_b32 v34, v191, v187, s37
    v_perm_b32 v38, v191, v187, s38
    s_waitcnt vmcnt(22)
    s_bfe_u32 s40, s39, 0xd0007
    buffer_load_dwordx4 v[208:211], v2, s[24:27], s40 offen
    buffer_load_dwordx4 v[160:163], v1, s[20:23], s39 offen offset:1536 nt
    buffer_load_dwordx4 v[164:167], v1, s[20:23], s39 offen offset:1792 nt
    v_perm_b32 v11, v196, v192, s37
    v_perm_b32 v15, v196, v192, s38
    v_perm_b32 v19, v197, v193, s37
    v_perm_b32 v23, v197, v193, s38
    v_perm_b32 v27, v198, v194, s37
    v_perm_b32 v31, v198, v194, s38
    v_perm_b32 v35, v199, v195, s37
    v_perm_b32 v39, v199, v195, s38
    s_waitcnt lgkmcnt(0)
    v_readfirstlane_b32 s49, v217
    v_mfma_f32_16x16x32_bf16 v[40:43], v[212:215], v[8:11], v[40:43]
    v_mfma_f32_16x16x32_bf16 v[44:47], v[212:215], v[12:15], v[44:47]
    v_mfma_f32_16x16x32_bf16 v[48:51], v[212:215], v[16:19], v[48:51]
    v_mfma_f32_16x16x32_bf16 v[52:55], v[212:215], v[20:23], v[52:55]
    v_mfma_f32_16x16x32_bf16 v[56:59], v[212:215], v[24:27], v[56:59]
    v_mfma_f32_16x16x32_bf16 v[60:63], v[212:215], v[28:31], v[60:63]
    v_mfma_f32_16x16x32_bf16 v[64:67], v[212:215], v[32:35], v[64:67]
    v_mfma_f32_16x16x32_bf16 v[68:71], v[212:215], v[36:39], v[68:71]
L_next:
    s_add_u32 s50, s50, 1
    s_bitcmp0_b64 s[52:53], s50
    s_cbranch_scc1 L_nomeet
    s_barrier
L_nomeet:
    s_bitcmp1_b64 s[54:55], s50
    s_cbranch_scc1 L_slow
L_sel:
    s_and_b32 s51, s51, 255
    s_add_u32 s51, s51, s49
L_disp:
    s_cmp_lt_u32 s51, 256
    s_cbranch_scc1 L_body_9
    s_cmp_lt_u32 s51, 512
    s_cbranch_scc1 L_body_10
    s_cmp_lt_u32 s51, 768
    s_cbranch_scc1 L_body_11
    s_branch L_body_12
L_slow:
    s_cmp_eq_u32 s50, 63
    s_cbranch_scc1 L_last
    ds_write_b128 v3, v[40:43] offset:0
    ds_write_b128 v3, v[44:47] offset:1024
    ds_write_b128 v3, v[48:51] offset:2048
    ds_write_b128 v3, v[52:55] offset:3072
    ds_write_b128 v3, v[56:59] offset:4096
    ds_write_b128 v3, v[60:63] offset:5120
    ds_write_b128 v3, v[64:67] offset:6144
    ds_write_b128 v3, v[68:71] offset:7168
    v_pk_mov_b32 v[40:41], 0, 0
    v_pk_mov_b32 v[42:43], 0, 0
    v_pk_mov_b32 v[44:45], 0, 0
    v_pk_mov_b32 v[46:47], 0, 0
    v_pk_mov_b32 v[48:49], 0, 0
    v_pk_mov_b32 v[50:51], 0, 0
    v_pk_mov_b32 v[52:53], 0, 0
    v_pk_mov_b32 v[54:55], 0, 0
    v_pk_mov_b32 v[56:57], 0, 0
    v_pk_mov_b32 v[58:59], 0, 0
    v_pk_mov_b32 v[60:61], 0, 0
    v_pk_mov_b32 v[62:63], 0, 0
    v_pk_mov_b32 v[64:65], 0, 0
    v_pk_mov_b32 v[66:67], 0, 0
    v_pk_mov_b32 v[68:69], 0, 0
    v_pk_mov_b32 v[70:71], 0, 0
    s_branch L_sel
L_body_10:
    s_waitcnt vmcnt(21)
    s_xor_b32 s39, s39, 0x800
    buffer_load_dwordx4 v[168:171], v1, s[20:23], s39 offen nt
    buffer_load_dwordx4 v[172:175], v1, s[20:23], s39 offen offset:256 nt
    v_perm_b32 v8, v76, v72, s37
    v_perm_b32 v12, v76, v72, s38
    v_perm_b32 v16, v77, v73, s37
    v_perm_b32 v20, v77, v73, s38
    v_perm_b32 v24, v78, v74, s37
    v_perm_b32 v28, v78, v74, s38
    v_perm_b32 v32, v79, v75, s37
    v_perm_b32 v36, v79, v75, s38
    s_waitcnt vmcnt(20)
    buffer_load_dwordx4 v[176:179], v1, s[20:23], s39 offen offset:512 nt
    buffer_load_dwordx4 v[180:183], v1, s[20:23], s39 offen offset:768 nt
    v_perm_b32 v9, v84, v80, s37
    v_perm_b32 v13, v84, v80, s38
    v_perm_b32 v17, v85, v81, s37
    v_perm_b32 v21, v85, v81, s38
    v_perm_b32 v25, v86, v82, s37
    v_perm_b32 v29, v86, v82, s38
    v_perm_b32 v33, v87, v83, s37
    v_perm_b32 v37, v87, v83, s38
    s_waitcnt vmcnt(20)
    buffer_load_dwordx4 v[184:187], v1, s[20:23], s39 offen offset:1024 nt
    buffer_load_dwordx4 v[188:191], v1, s[20:23], s39 offen offset:1280 nt
    v_perm_b32 v10, v92, v88, s37
    v_perm_b32 v14, v92, v88, s38
    v_perm_b32 v18, v93, v89, s37
    v_perm_b32 v22, v93, v89, s38
    v_perm_b32 v26, v94, v90, s37
    v_perm_b32 v30, v94, v90, s38
    v_perm_b32 v34, v95, v91, s37
    v_perm_b32 v38, v95, v91, s38
    s_waitcnt vmcnt(20)
    s_bfe_u32 s40, s39, 0xd0007
    buffer_load_dwordx4 v[212:215], v2, s[24:27], s40 offen
    buffer_load_dwordx4 v[192:195], v1, s[20:23], s39 offen offset:1536 nt
    buffer_load_dwordx4 v[196:199], v1, s[20:23], s39 offen offset:1792 nt
    v_perm_b32 v11, v100, v96, s37
    v_perm_b32 v15, v100, v96, s38
    v_perm_b32 v19, v101, v97, s37
    v_perm_b32 v23, v101, v97, s38
    v_perm_b32 v27, v102, v98, s37
    v_perm_b32 v31, v102, v98, s38
    v_perm_b32 v35, v103, v99, s37
    v_perm_b32 v39, v103, v99, s38
    v_mfma_f32_16x16x32_bf16 v[40:43], v[200:203], v[8:11], v[40:43]
    v_mfma_f32_16x16x32_bf16 v[44:47], v[200:203], v[12:15], v[44:47]
    v_mfma_f32_16x16x32_bf16 v[48:51], v[200:203], v[16:19], v[48:51]
    v_mfma_f32_16x16x32_bf16 v[52:55], v[200:203], v[20:23], v[52:55]
    v_mfma_f32_16x16x32_bf16 v[56:59], v[200:203], v[24:27], v[56:59]
    v_mfma_f32_16x16x32_bf16 v[60:63], v[200:203], v[28:31], v[60:63]
    v_mfma_f32_16x16x32_bf16 v[64:67], v[200:203], v[32:35], v[64:67]
    v_mfma_f32_16x16x32_bf16 v[68:71], v[200:203], v[36:39], v[68:71]
    s_waitcnt vmcnt(21)
    s_or_b32 s57, s57, 0x13800
    s_add_u32 s57, s57, 0x800
    s_and_b32 s57, s57, 0xfffec7ff
    s_cmp_ge_u32 s57, 0x100000
    s_cselect_b64 s[20:21], s[44:45], s[20:21]
    s_cselect_b64 s[24:25], s[12:13], s[24:25]
    s_xor_b32 s39, s57, s56
    buffer_load_dwordx4 v[72:75], v1, s[20:23], s39 offen nt
    buffer_load_dwordx4 v[76:79], v1, s[20:23], s39 offen offset:256 nt
    v_perm_b32 v8, v108, v104, s37
    v_perm_b32 v12, v108, v104, s38
    v_perm_b32 v16, v109, v105, s37
    v_perm_b32 v20, v109, v105, s38
    v_perm_b32 v24, v110, v106, s37
    v_perm_b32 v28, v110, v106, s38
    v_perm_b32 v32, v111, v107, s37
    v_perm_b32 v36, v111, v107, s38
    s_waitcnt vmcnt(20)
    buffer_load_dwordx4 v[80:83], v1, s[20:23], s39 offen offset:512 nt
    buffer_load_dwordx4 v[84:87], v1, s[20:23], s39 offen offset:768 nt
    v_perm_b32 v9, v116, v112, s37
    v_perm_b32 v13, v116, v112, s38
    v_perm_b32 v17, v117, v113, s37
    v_perm_b32 v21, v117, v113, s38
    v_perm_b32 v25, v118, v114, s37
    v_perm_b32 v29, v118, v114, s38
    v_perm_b32 v33, v119, v115, s37
    v_perm_b32 v37, v119, v115, s38
    s_waitcnt vmcnt(20)
    buffer_load_dwordx4 v[88:91], v1, s[20:23], s39 offen offset:1024 nt
    buffer_load_dwordx4 v[92:95], v1, s[20:23], s39 offen offset:1280 nt
    v_perm_b32 v10, v124, v120, s37
    v_perm_b32 v14, v124, v120, s38
    v_perm_b32 v18, v125, v121, s37
    v_perm_b32 v22, v125, v121, s38
    v_perm_b32 v26, v126, v122, s37
    v_perm_b32 v30, v126, v122, s38
    v_perm_b32 v34, v127, v123, s37
    v_perm_b32 v38, v127, v123, s38
    s_waitcnt vmcnt(20)
    s_bfe_u32 s40, s39, 0xd0007
    buffer_load_dwordx4 v[200:203], v2, s[24:27], s40 offen
    buffer_load_dwordx4 v[96:99], v1, s[20:23], s39 offen offset:1536 nt
    buffer_load_dwordx4 v[100:103], v1, s[20:23], s39 offen offset:1792 nt
    v_perm_b32 v11, v132, v128, s37
    v_perm_b32 v15, v132, v128, s38
    v_perm_b32 v19, v133, v129, s37
    v_perm_b32 v23, v133, v129, s38
    v_perm_b32 v27, v134, v130, s37
    v_perm_b32 v31, v134, v130, s38
    v_perm_b32 v35, v135, v131, s37
    v_perm_b32 v39, v135, v131, s38
    v_mfma_f32_16x16x32_bf16 v[40:43], v[204:207], v[8:11], v[40:43]
    v_mfma_f32_16x16x32_bf16 v[44:47], v[204:207], v[12:15], v[44:47]
    v_mfma_f32_16x16x32_bf16 v[48:51], v[204:207], v[16:19], v[48:51]
    v_mfma_f32_16x16x32_bf16 v[52:55], v[204:207], v[20:23], v[52:55]
    v_mfma_f32_16x16x32_bf16 v[56:59], v[204:207], v[24:27], v[56:59]
    v_mfma_f32_16x16x32_bf16 v[60:63], v[204:207], v[28:31], v[60:63]
    v_mfma_f32_16x16x32_bf16 v[64:67], v[204:207], v[32:35], v[64:67]
    v_mfma_f32_16x16x32_bf16 v[68:71], v[204:207], v[36:39], v[68:71]
    s_waitcnt vmcnt(21)
    s_xor_b32 s39, s39, 0x800
    buffer_load_dwordx4 v[104:107], v1, s[20:23], s39 offen nt
    buffer_load_dwordx4 v[108:111], v1, s[20:23], s39 offen offset:256 nt
    v_perm_b32 v8, v140, v136, s37
    v_perm_b32 v12, v140, v136, s38
    v_perm_b32 v16, v141, v137, s37
    v_perm_b32 v20, v141, v137, s38
    v_perm_b32 v24, v142, v138, s37
    v_perm_b32 v28, v142, v138, s38
    v_perm_b32 v32, v143, v139, s37
    v_perm_b32 v36, v143, v139, s38
    s_waitcnt vmcnt(20)
    buffer_load_dwordx4 v[112:115], v1, s[20:23], s39 offen offset:512 nt
    buffer_load_dwordx4 v[116:119], v1, s[20:23], s39 offen offset:768 nt
    v_perm_b32 v9, v148, v144, s37
    v_perm_b32 v13, v148, v144, s38
    v_perm_b32 v17, v149, v145, s37
    v_perm_b32 v21, v149, v145, s38
    v_perm_b32 v25, v150, v146, s37
    v_perm_b32 v29, v150, v146, s38
    v_perm_b32 v33, v151, v147, s37
    v_perm_b32 v37, v151, v147, s38
    s_waitcnt vmcnt(20)
    buffer_load_dwordx4 v[120:123], v1, s[20:23], s39 offen offset:1024 nt
    buffer_load_dwordx4 v[124:127], v1, s[20:23], s39 offen offset:1280 nt
    v_perm_b32 v10, v156, v152, s37
    v_perm_b32 v14, v156, v152, s38
    v_perm_b32 v18, v157, v153, s37
    v_perm_b32 v22, v157, v153, s38
    v_perm_b32 v26, v158, v154, s37
    v_perm_b32 v30, v158, v154, s38
    v_perm_b32 v34, v159, v155, s37
    v_perm_b32 v38, v159, v155, s38
    s_waitcnt vmcnt(20)
    s_bfe_u32 s40, s39, 0xd0007
    buffer_load_dwordx4 v[204:207], v2, s[24:27], s40 offen
    buffer_load_dwordx4 v[128:131], v1, s[20:23], s39 offen offset:1536 nt
    buffer_load_dwordx4 v[132:135], v1, s[20:23], s39 offen offset:1792 nt
    v_perm_b32 v11, v164, v160, s37
    v_perm_b32 v15, v164, v160, s38
    v_perm_b32 v19, v165, v161, s37
    v_perm_b32 v23, v165, v161, s38
    v_perm_b32 v27, v166, v162, s37
    v_perm_b32 v31, v166, v162, s38
    v_perm_b32 v35, v167, v163, s37
    v_perm_b32 v39, v167, v163, s38
    v_mfma_f32_16x16x32_bf16 v[40:43], v[208:211], v[8:11], v[40:43]
    v_mfma_f32_16x16x32_bf16 v[44:47], v[208:211], v[12:15], v[44:47]
    v_mfma_f32_16x16x32_bf16 v[48:51], v[208:211], v[16:19], v[48:51]
    v_mfma_f32_16x16x32_bf16 v[52:55], v[208:211], v[20:23], v[52:55]
    v_mfma_f32_16x16x32_bf16 v[56:59], v[208:211], v[24:27], v[56:59]
    v_mfma_f32_16x16x32_bf16 v[60:63], v[208:211], v[28:31], v[60:63]
    v_mfma_f32_16x16x32_bf16 v[64:67], v[208:211], v[32:35], v[64:67]
    v_mfma_f32_16x16x32_bf16 v[68:71], v[208:211], v[36:39], v[68:71]
    s_waitcnt vmcnt(21)
    s_xor_b32 s39, s39, 0x1800
    buffer_load_dwordx4 v[136:139], v1, s[20:23], s39 offen nt
    buffer_load_dwordx4 v[140:143], v1, s[20:23], s39 offen offset:256 nt
    v_perm_b32 v8, v172, v168, s37
    v_perm_b32 v12, v172, v168, s38
    v_perm_b32 v16, v173, v169, s37
    v_perm_b32 v20, v173, v169, s38
    v_perm_b32 v24, v174, v170, s37
    v_perm_b32 v28, v174, v170, s38
    v_perm_b32 v32, v175, v171, s37
    v_perm_b32 v36, v175, v171, s38
    s_waitcnt vmcnt(20)
    buffer_load_dwordx4 v[144:147], v1, s[20:23], s39 offen offset:512 nt
    buffer_load_dwordx4 v[148:151], v1, s[20:23], s39 offen offset:768 nt
    v_perm_b32 v9, v180, v176, s37
    v_perm_b32 v13, v180, v176, s38
    v_perm_b32 v17, v181, v177, s37
    v_perm_b32 v21, v181, v177, s38
    v_perm_b32 v25, v182, v178, s37
    v_perm_b32 v29, v182, v178, s38
    v_perm_b32 v33, v183, v179, s37
    v_perm_b32 v37, v183, v179, s38
    ds_read_b32 v217, v216 offset:8704
    s_waitcnt vmcnt(20)
    buffer_load_dwordx4 v[152:155], v1, s[20:23], s39 offen offset:1024 nt
    buffer_load_dwordx4 v[156:159], v1, s[20:23], s39 offen offset:1280 nt
    v_perm_b32 v10, v188, v184, s37
    v_perm_b32 v14, v188, v184, s38
    v_perm_b32 v18, v189, v185, s37
    v_perm_b32 v22, v189, v185, s38
    v_perm_b32 v26, v190, v186, s37
    v_perm_b32 v30, v190, v186, s38
    v_perm_b32 v34, v191, v187, s37
    v_perm_b32 v38, v191, v187, s38
    s_waitcnt vmcnt(20)
    s_bfe_u32 s40, s39, 0xd0007
    buffer_load_dwordx4 v[208:211], v2, s[24:27], s40 offen
    buffer_load_dwordx4 v[160:163], v1, s[20:23], s39 offen offset:1536 nt
    buffer_load_dwordx4 v[164:167], v1, s[20:23], s39 offen offset:1792 nt
    v_perm_b32 v11, v196, v192, s37
    v_perm_b32 v15, v196, v192, s38
    v_perm_b32 v19, v197, v193, s37
    v_perm_b32 v23, v197, v193, s38
    v_perm_b32 v27, v198, v194, s37
    v_perm_b32 v31, v198, v194, s38
    v_perm_b32 v35, v199, v195, s37
    v_perm_b32 v39, v199, v195, s38
    s_waitcnt lgkmcnt(0)
    v_readfirstlane_b32 s49, v217
    v_mfma_f32_16x16x32_bf16 v[40:43], v[212:215], v[8:11], v[40:43]
    v_mfma_f32_16x16x32_bf16 v[44:47], v[212:215], v[12:15], v[44:47]
    v_mfma_f32_16x16x32_bf16 v[48:51], v[212:215], v[16:19], v[48:51]
    v_mfma_f32_16x16x32_bf16 v[52:55], v[212:215], v[20:23], v[52:55]
    v_mfma_f32_16x16x32_bf16 v[56:59], v[212:215], v[24:27], v[56:59]
    v_mfma_f32_16x16x32_bf16 v[60:63], v[212:215], v[28:31], v[60:63]
    v_mfma_f32_16x16x32_bf16 v[64:67], v[212:215], v[32:35], v[64:67]
    v_mfma_f32_16x16x32_bf16 v[68:71], v[212:215], v[36:39], v[68:71]
    s_branch L_next
L_body_12:
    s_waitcnt vmcnt(25)
    s_xor_b32 s39, s39, 0x800
    buffer_load_dwordx4 v[168:171], v1, s[20:23], s39 offen nt
    buffer_load_dwordx4 v[172:175], v1, s[20:23], s39 offen offset:256 nt
    v_perm_b32 v8, v76, v72, s37
    v_perm_b32 v12, v76, v72, s38
    v_perm_b32 v16, v77, v73, s37
    v_perm_b32 v20, v77, v73, s38
    v_perm_b32 v24, v78, v74, s37
    v_perm_b32 v28, v78, v74, s38
    v_perm_b32 v32, v79, v75, s37
    v_perm_b32 v36, v79, v75, s38
    s_waitcnt vmcnt(25)
    buffer_load_dwordx4 v[176:179], v1, s[20:23], s39 offen offset:512 nt
    buffer_load_dwordx4 v[180:183], v1, s[20:23], s39 offen offset:768 nt
    v_perm_b32 v9, v84, v80, s37
    v_perm_b32 v13, v84, v80, s38
    v_perm_b32 v17, v85, v81, s37
    v_perm_b32 v21, v85, v81, s38
    v_perm_b32 v25, v86, v82, s37
    v_perm_b32 v29, v86, v82, s38
    v_perm_b32 v33, v87, v83, s37
    v_perm_b32 v37, v87, v83, s38
    s_waitcnt vmcnt(25)
    buffer_load_dwordx4 v[184:187], v1, s[20:23], s39 offen offset:1024 nt
    buffer_load_dwordx4 v[188:191], v1, s[20:23], s39 offen offset:1280 nt
    v_perm_b32 v10, v92, v88, s37
    v_perm_b32 v14, v92, v88, s38
    v_perm_b32 v18, v93, v89, s37
    v_perm_b32 v22, v93, v89, s38
    v_perm_b32 v26, v94, v90, s37
    v_perm_b32 v30, v94, v90, s38
    v_perm_b32 v34, v95, v91, s37
    v_perm_b32 v38, v95, v91, s38
    s_waitcnt vmcnt(24)
    s_bfe_u32 s40, s39, 0xd0007
    buffer_load_dwordx4 v[212:215], v2, s[24:27], s40 offen
    buffer_load_dwordx4 v[192:195], v1, s[20:23], s39 offen offset:1536 nt
    buffer_load_dwordx4 v[196:199], v1, s[20:23], s39 offen offset:1792 nt
    v_perm_b32 v11, v100, v96, s37
    v_perm_b32 v15, v100, v96, s38
    v_perm_b32 v19, v101, v97, s37
    v_perm_b32 v23, v101, v97, s38
    v_perm_b32 v27, v102, v98, s37
    v_perm_b32 v31, v102, v98, s38
    v_perm_b32 v35, v103, v99, s37
    v_perm_b32 v39, v103, v99, s38
    v_mfma_f32_16x16x32_bf16 v[40:43], v[200:203], v[8:11], v[40:43]
    v_mfma_f32_16x16x32_bf16 v[44:47], v[200:203], v[12:15], v[44:47]
    v_mfma_f32_16x16x32_bf16 v[48:51], v[200:203], v[16:19], v[48:51]
    v_mfma_f32_16x16x32_bf16 v[52:55], v[200:203], v[20:23], v[52:55]
    v_mfma_f32_16x16x32_bf16 v[56:59], v[200:203], v[24:27], v[56:59]
    v_mfma_f32_16x16x32_bf16 v[60:63], v[200:203], v[28:31], v[60:63]
    v_mfma_f32_16x16x32_bf16 v[64:67], v[200:203], v[32:35], v[64:67]
    v_mfma_f32_16x16x32_bf16 v[68:71], v[200:203], v[36:39], v[68:71]
    s_waitcnt vmcnt(25)
    s_or_b32 s57, s57, 0x13800
    s_add_u32 s57, s57, 0x800
    s_and_b32 s57, s57, 0xfffec7ff
    s_cmp_ge_u32 s57, 0x100000
    s_cselect_b64 s[20:21], s[44:45], s[20:21]
    s_cselect_b64 s[24:25], s[12:13], s[24:25]
    s_xor_b32 s39, s57, s56
    buffer_load_dwordx4 v[72:75], v1, s[20:23], s39 offen nt
    buffer_load_dwordx4 v[76:79], v1, s[20:23], s39 offen offset:256 nt
    v_perm_b32 v8, v108, v104, s37
    v_perm_b32 v12, v108, v104, s38
    v_perm_b32 v16, v109, v105, s37
    v_perm_b32 v20, v109, v105, s38
    v_perm_b32 v24, v110, v106, s37
    v_perm_b32 v28, v110, v106, s38
    v_perm_b32 v32, v111, v107, s37
    v_perm_b32 v36, v111, v107, s38
    s_waitcnt vmcnt(25)
    buffer_load_dwordx4 v[80:83], v1, s[20:23], s39 offen offset:512 nt
    buffer_load_dwordx4 v[84:87], v1, s[20:23], s39 offen offset:768 nt
    v_perm_b32 v9, v116, v112, s37
    v_perm_b32 v13, v116, v112, s38
    v_perm_b32 v17, v117, v113, s37
    v_perm_b32 v21, v117, v113, s38
    v_perm_b32 v25, v118, v114, s37
    v_perm_b32 v29, v118, v114, s38
    v_perm_b32 v33, v119, v115, s37
    v_perm_b32 v37, v119, v115, s38
    s_waitcnt vmcnt(25)
    buffer_load_dwordx4 v[88:91], v1, s[20:23], s39 offen offset:1024 nt
    buffer_load_dwordx4 v[92:95], v1, s[20:23], s39 offen offset:1280 nt
    v_perm_b32 v10, v124, v120, s37
    v_perm_b32 v14, v124, v120, s38
    v_perm_b32 v18, v125, v121, s37
    v_perm_b32 v22, v125, v121, s38
    v_perm_b32 v26, v126, v122, s37
    v_perm_b32 v30, v126, v122, s38
    v_perm_b32 v34, v127, v123, s37
    v_perm_b32 v38, v127, v123, s38
    s_waitcnt vmcnt(24)
    s_bfe_u32 s40, s39, 0xd0007
    buffer_load_dwordx4 v[200:203], v2, s[24:27], s40 offen
    buffer_load_dwordx4 v[96:99], v1, s[20:23], s39 offen offset:1536 nt
    buffer_load_dwordx4 v[100:103], v1, s[20:23], s39 offen offset:1792 nt
    v_perm_b32 v11, v132, v128, s37
    v_perm_b32 v15, v132, v128, s38
    v_perm_b32 v19, v133, v129, s37
    v_perm_b32 v23, v133, v129, s38
    v_perm_b32 v27, v134, v130, s37
    v_perm_b32 v31, v134, v130, s38
    v_perm_b32 v35, v135, v131, s37
    v_perm_b32 v39, v135, v131, s38
    v_mfma_f32_16x16x32_bf16 v[40:43], v[204:207], v[8:11], v[40:43]
    v_mfma_f32_16x16x32_bf16 v[44:47], v[204:207], v[12:15], v[44:47]
    v_mfma_f32_16x16x32_bf16 v[48:51], v[204:207], v[16:19], v[48:51]
    v_mfma_f32_16x16x32_bf16 v[52:55], v[204:207], v[20:23], v[52:55]
    v_mfma_f32_16x16x32_bf16 v[56:59], v[204:207], v[24:27], v[56:59]
    v_mfma_f32_16x16x32_bf16 v[60:63], v[204:207], v[28:31], v[60:63]
    v_mfma_f32_16x16x32_bf16 v[64:67], v[204:207], v[32:35], v[64:67]
    v_mfma_f32_16x16x32_bf16 v[68:71], v[204:207], v[36:39], v[68:71]
    s_waitcnt vmcnt(25)
    s_xor_b32 s39, s39, 0x800
    buffer_load_dwordx4 v[104:107], v1, s[20:23], s39 offen nt
    buffer_load_dwordx4 v[108:111], v1, s[20:23], s39 offen offset:256 nt
    v_perm_b32 v8, v140, v136, s37
    v_perm_b32 v12, v140, v136, s38
    v_perm_b32 v16, v141, v137, s37
    v_perm_b32 v20, v141, v137, s38
    v_perm_b32 v24, v142, v138, s37
    v_perm_b32 v28, v142, v138, s38
    v_perm_b32 v32, v143, v139, s37
    v_perm_b32 v36, v143, v139, s38
    s_waitcnt vmcnt(25)
    buffer_load_dwordx4 v[112:115], v1, s[20:23], s39 offen offset:512 nt
    buffer_load_dwordx4 v[116:119], v1, s[20:23], s39 offen offset:768 nt
    v_perm_b32 v9, v148, v144, s37
    v_perm_b32 v13, v148, v144, s38
    v_perm_b32 v17, v149, v145, s37
    v_perm_b32 v21, v149, v145, s38
    v_perm_b32 v25, v150, v146, s37
    v_perm_b32 v29, v150, v146, s38
    v_perm_b32 v33, v151, v147, s37
    v_perm_b32 v37, v151, v147, s38
    s_waitcnt vmcnt(25)
    buffer_load_dwordx4 v[120:123], v1, s[20:23], s39 offen offset:1024 nt
    buffer_load_dwordx4 v[124:127], v1, s[20:23], s39 offen offset:1280 nt
    v_perm_b32 v10, v156, v152, s37
    v_perm_b32 v14, v156, v152, s38
    v_perm_b32 v18, v157, v153, s37
    v_perm_b32 v22, v157, v153, s38
    v_perm_b32 v26, v158, v154, s37
    v_perm_b32 v30, v158, v154, s38
    v_perm_b32 v34, v159, v155, s37
    v_perm_b32 v38, v159, v155, s38
    s_waitcnt vmcnt(24)
    s_bfe_u32 s40, s39, 0xd0007
    buffer_load_dwordx4 v[204:207], v2, s[24:27], s40 offen
    buffer_load_dwordx4 v[128:131], v1, s[20:23], s39 offen offset:1536 nt
    buffer_load_dwordx4 v[132:135], v1, s[20:23], s39 offen offset:1792 nt
    v_perm_b32 v11, v164, v160, s37
    v_perm_b32 v15, v164, v160, s38
    v_perm_b32 v19, v165, v161, s37
    v_perm_b32 v23, v165, v161, s38
    v_perm_b32 v27, v166, v162, s37
    v_perm_b32 v31, v166, v162, s38
    v_perm_b32 v35, v167, v163, s37
    v_perm_b32 v39, v167, v163, s38
    v_mfma_f32_16x16x32_bf16 v[40:43], v[208:211], v[8:11], v[40:43]
    v_mfma_f32_16x16x32_bf16 v[44:47], v[208:211], v[12:15], v[44:47]
    v_mfma_f32_16x16x32_bf16 v[48:51], v[208:211], v[16:19], v[48:51]
    v_mfma_f32_16x16x32_bf16 v[52:55], v[208:211], v[20:23], v[52:55]
    v_mfma_f32_16x16x32_bf16 v[56:59], v[208:211], v[24:27], v[56:59]
    v_mfma_f32_16x16x32_bf16 v[60:63], v[208:211], v[28:31], v[60:63]
    v_mfma_f32_16x16x32_bf16 v[64:67], v[208:211], v[32:35], v[64:67]
    v_mfma_f32_16x16x32_bf16 v[68:71], v[208:211], v[36:39], v[68:71]
    s_waitcnt vmcnt(25)
    s_xor_b32 s39, s39, 0x1800
    buffer_load_dwordx4 v[136:139], v1, s[20:23], s39 offen nt
    buffer_load_dwordx4 v[140:143], v1, s[20:23], s39 offen offset:256 nt
    v_perm_b32 v8, v172, v168, s37
    v_perm_b32 v12, v172, v168, s38
    v_perm_b32 v16, v173, v169, s37
    v_perm_b32 v20, v173, v169, s38
    v_perm_b32 v24, v174, v170, s37
    v_perm_b32 v28, v174, v170, s38
    v_perm_b32 v32, v175, v171, s37
    v_perm_b32 v36, v175, v171, s38
    s_waitcnt vmcnt(25)
    buffer_load_dwordx4 v[144:147], v1, s[20:23], s39 offen offset:512 nt
    buffer_load_dwordx4 v[148:151], v1, s[20:23], s39 offen offset:768 nt
    v_perm_b32 v9, v180, v176, s37
    v_perm_b32 v13, v180, v176, s38
    v_perm_b32 v17, v181, v177, s37
    v_perm_b32 v21, v181, v177, s38
    v_perm_b32 v25, v182, v178, s37
    v_perm_b32 v29, v182, v178, s38
    v_perm_b32 v33, v183, v179, s37
    v_perm_b32 v37, v183, v179, s38
    ds_read_b32 v217, v216 offset:8704
    s_waitcnt vmcnt(25)
    buffer_load_dwordx4 v[152:155], v1, s[20:23], s39 offen offset:1024 nt
    buffer_load_dwordx4 v[156:159], v1, s[20:23], s39 offen offset:1280 nt
    v_perm_b32 v10, v188, v184, s37
    v_perm_b32 v14, v188, v184, s38
    v_perm_b32 v18, v189, v185, s37
    v_perm_b32 v22, v189, v185, s38
    v_perm_b32 v26, v190, v186, s37
    v_perm_b32 v30, v190, v186, s38
    v_perm_b32 v34, v191, v187, s37
    v_perm_b32 v38, v191, v187, s38
    s_waitcnt vmcnt(24)
    s_bfe_u32 s40, s39, 0xd0007
    buffer_load_dwordx4 v[208:211], v2, s[24:27], s40 offen
    buffer_load_dwordx4 v[160:163], v1, s[20:23], s39 offen offset:1536 nt
    buffer_load_dwordx4 v[164:167], v1, s[20:23], s39 offen offset:1792 nt
    v_perm_b32 v11, v196, v192, s37
    v_perm_b32 v15, v196, v192, s38
    v_perm_b32 v19, v197, v193, s37
    v_perm_b32 v23, v197, v193, s38
    v_perm_b32 v27, v198, v194, s37
    v_perm_b32 v31, v198, v194, s38
    v_perm_b32 v35, v199, v195, s37
    v_perm_b32 v39, v199, v195, s38
    s_waitcnt lgkmcnt(0)
    v_readfirstlane_b32 s49, v217
    v_mfma_f32_16x16x32_bf16 v[40:43], v[212:215], v[8:11], v[40:43]
    v_mfma_f32_16x16x32_bf16 v[44:47], v[212:215], v[12:15], v[44:47]
    v_mfma_f32_16x16x32_bf16 v[48:51], v[212:215], v[16:19], v[48:51]
    v_mfma_f32_16x16x32_bf16 v[52:55], v[212:215], v[20:23], v[52:55]
    v_mfma_f32_16x16x32_bf16 v[56:59], v[212:215], v[24:27], v[56:59]
    v_mfma_f32_16x16x32_bf16 v[60:63], v[212:215], v[28:31], v[60:63]
    v_mfma_f32_16x16x32_bf16 v[64:67], v[212:215], v[32:35], v[64:67]
    v_mfma_f32_16x16x32_bf16 v[68:71], v[212:215], v[36:39], v[68:71]
    s_branch L_next
L_body_9:
    s_waitcnt vmcnt(18)
    s_xor_b32 s39, s39, 0x800
    buffer_load_dwordx4 v[168:171], v1, s[20:23], s39 offen nt
    buffer_load_dwordx4 v[172:175], v1, s[20:23], s39 offen offset:256 nt
    v_perm_b32 v8, v76, v72, s37
    v_perm_b32 v12, v76, v72, s38
    v_perm_b32 v16, v77, v73, s37
    v_perm_b32 v20, v77, v73, s38
    v_perm_b32 v24, v78, v74, s37
    v_perm_b32 v28, v78, v74, s38
    v_perm_b32 v32, v79, v75, s37
    v_perm_b32 v36, v79, v75, s38
    s_waitcnt vmcnt(18)
    buffer_load_dwordx4 v[176:179], v1, s[20:23], s39 offen offset:512 nt
    buffer_load_dwordx4 v[180:183], v1, s[20:23], s39 offen offset:768 nt
    v_perm_b32 v9, v84, v80, s37
    v_perm_b32 v13, v84, v80, s38
    v_perm_b32 v17, v85, v81, s37
    v_perm_b32 v21, v85, v81, s38
    v_perm_b32 v25, v86, v82, s37
    v_perm_b32 v29, v86, v82, s38
    v_perm_b32 v33, v87, v83, s37
    v_perm_b32 v37, v87, v83, s38
    s_waitcnt vmcnt(18)
    buffer_load_dwordx4 v[184:187], v1, s[20:23], s39 offen offset:1024 nt
    buffer_load_dwordx4 v[188:191], v1, s[20:23], s39 offen offset:1280 nt
    v_perm_b32 v10, v92, v88, s37
    v_perm_b32 v14, v92, v88, s38
    v_perm_b32 v18, v93, v89, s37
    v_perm_b32 v22, v93, v89, s38
    v_perm_b32 v26, v94, v90, s37
    v_perm_b32 v30, v94, v90, s38
    v_perm_b32 v34, v95, v91, s37
    v_perm_b32 v38, v95, v91, s38
    s_waitcnt vmcnt(18)
    s_bfe_u32 s40, s39, 0xd0007
    buffer_load_dwordx4 v[212:215], v2, s[24:27], s40 offen
    buffer_load_dwordx4 v[192:195], v1, s[20:23], s39 offen offset:1536 nt
    buffer_load_dwordx4 v[196:199], v1, s[20:23], s39 offen offset:1792 nt
    v_perm_b32 v11, v100, v96, s37
    v_perm_b32 v15, v100, v96, s38
    v_perm_b32 v19, v101, v97, s37
    v_perm_b32 v23, v101, v97, s38
    v_perm_b32 v27, v102, v98, s37
    v_perm_b32 v31, v102, v98, s38
    v_perm_b32 v35, v103, v99, s37
    v_perm_b32 v39, v103, v99, s38
    v_mfma_f32_16x16x32_bf16 v[40:43], v[200:203], v[8:11], v[40:43]
    v_mfma_f32_16x16x32_bf16 v[44:47], v[200:203], v[12:15], v[44:47]
    v_mfma_f32_16x16x32_bf16 v[48:51], v[200:203], v[16:19], v[48:51]
    v_mfma_f32_16x16x32_bf16 v[52:55], v[200:203], v[20:23], v[52:55]
    v_mfma_f32_16x16x32_bf16 v[56:59], v[200:203], v[24:27], v[56:59]
    v_mfma_f32_16x16x32_bf16 v[60:63], v[200:203], v[28:31], v[60:63]
    v_mfma_f32_16x16x32_bf16 v[64:67], v[200:203], v[32:35], v[64:67]
    v_mfma_f32_16x16x32_bf16 v[68:71], v[200:203], v[36:39], v[68:71]
    s_waitcnt vmcnt(18)
    s_or_b32 s57, s57, 0x13800
    s_add_u32 s57, s57, 0x800
    s_and_b32 s57, s57, 0xfffec7ff
    s_cmp_ge_u32 s57, 0x100000
    s_cselect_b64 s[20:21], s[44:45], s[20:21]
    s_cselect_b64 s[24:25], s[12:13], s[24:25]
    s_xor_b32 s39, s57, s56
    buffer_load_dwordx4 v[72:75], v1, s[20:23], s39 offen nt
    buffer_load_dwordx4 v[76:79], v1, s[20:23], s39 offen offset:256 nt
    v_perm_b32 v8, v108, v104, s37
    v_perm_b32 v12, v108, v104, s38
    v_perm_b32 v16, v109, v105, s37
    v_perm_b32 v20, v109, v105, s38
    v_perm_b32 v24, v110, v106, s37
    v_perm_b32 v28, v110, v106, s38
    v_perm_b32 v32, v111, v107, s37
    v_perm_b32 v36, v111, v107, s38
    s_waitcnt vmcnt(18)
    buffer_load_dwordx4 v[80:83], v1, s[20:23], s39 offen offset:512 nt
    buffer_load_dwordx4 v[84:87], v1, s[20:23], s39 offen offset:768 nt
    v_perm_b32 v9, v116, v112, s37
    v_perm_b32 v13, v116, v112, s38
    v_perm_b32 v17, v117, v113, s37
    v_perm_b32 v21, v117, v113, s38
    v_perm_b32 v25, v118, v114, s37
    v_perm_b32 v29, v118, v114, s38
    v_perm_b32 v33, v119, v115, s37
    v_perm_b32 v37, v119, v115, s38
    s_waitcnt vmcnt(18)
    buffer_load_dwordx4 v[88:91], v1, s[20:23], s39 offen offset:1024 nt
    buffer_load_dwordx4 v[92:95], v1, s[20:23], s39 offen offset:1280 nt
    v_perm_b32 v10, v124, v120, s37
    v_perm_b32 v14, v124, v120, s38
    v_perm_b32 v18, v125, v121, s37
    v_perm_b32 v22, v125, v121, s38
    v_perm_b32 v26, v126, v122, s37
    v_perm_b32 v30, v126, v122, s38
    v_perm_b32 v34, v127, v123, s37
    v_perm_b32 v38, v127, v123, s38
    s_waitcnt vmcnt(18)
    s_bfe_u32 s40, s39, 0xd0007
    buffer_load_dwordx4 v[200:203], v2, s[24:27], s40 offen
    buffer_load_dwordx4 v[96:99], v1, s[20:23], s39 offen offset:1536 nt
    buffer_load_dwordx4 v[100:103], v1, s[20:23], s39 offen offset:1792 nt
    v_perm_b32 v11, v132, v128, s37
    v_perm_b32 v15, v132, v128, s38
    v_perm_b32 v19, v133, v129, s37
    v_perm_b32 v23, v133, v129, s38
    v_perm_b32 v27, v134, v130, s37
    v_perm_b32 v31, v134, v130, s38
    v_perm_b32 v35, v135, v131, s37
    v_perm_b32 v39, v135, v131, s38
    v_mfma_f32_16x16x32_bf16 v[40:43], v[204:207], v[8:11], v[40:43]
    v_mfma_f32_16x16x32_bf16 v[44:47], v[204:207], v[12:15], v[44:47]
    v_mfma_f32_16x16x32_bf16 v[48:51], v[204:207], v[16:19], v[48:51]
    v_mfma_f32_16x16x32_bf16 v[52:55], v[204:207], v[20:23], v[52:55]
    v_mfma_f32_16x16x32_bf16 v[56:59], v[204:207], v[24:27], v[56:59]
    v_mfma_f32_16x16x32_bf16 v[60:63], v[204:207], v[28:31], v[60:63]
    v_mfma_f32_16x16x32_bf16 v[64:67], v[204:207], v[32:35], v[64:67]
    v_mfma_f32_16x16x32_bf16 v[68:71], v[204:207], v[36:39], v[68:71]
    s_waitcnt vmcnt(18)
    s_xor_b32 s39, s39, 0x800
    buffer_load_dwordx4 v[104:107], v1, s[20:23], s39 offen nt
    buffer_load_dwordx4 v[108:111], v1, s[20:23], s39 offen offset:256 nt
    v_perm_b32 v8, v140, v136, s37
    v_perm_b32 v12, v140, v136, s38
    v_perm_b32 v16, v141, v137, s37
    v_perm_b32 v20, v141, v137, s38
    v_perm_b32 v24, v142, v138, s37
    v_perm_b32 v28, v142, v138, s38
    v_perm_b32 v32, v143, v139, s37
    v_perm_b32 v36, v143, v139, s38
    s_waitcnt vmcnt(18)
    buffer_load_dwordx4 v[112:115], v1, s[20:23], s39 offen offset:512 nt
    buffer_load_dwordx4 v[116:119], v1, s[20:23], s39 offen offset:768 nt
    v_perm_b32 v9, v148, v144, s37
    v_perm_b32 v13, v148, v144, s38
    v_perm_b32 v17, v149, v145, s37
    v_perm_b32 v21, v149, v145, s38
    v_perm_b32 v25, v150, v146, s37
    v_perm_b32 v29, v150, v146, s38
    v_perm_b32 v33, v151, v147, s37
    v_perm_b32 v37, v151, v147, s38
    s_waitcnt vmcnt(18)
    buffer_load_dwordx4 v[120:123], v1, s[20:23], s39 offen offset:1024 nt
    buffer_load_dwordx4 v[124:127], v1, s[20:23], s39 offen offset:1280 nt
    v_perm_b32 v10, v156, v152, s37
    v_perm_b32 v14, v156, v152, s38
    v_perm_b32 v18, v157, v153, s37
    v_perm_b32 v22, v157, v153, s38
    v_perm_b32 v26, v158, v154, s37
    v_perm_b32 v30, v158, v154, s38
    v_perm_b32 v34, v159, v155, s37
    v_perm_b32 v38, v159, v155, s38
    s_waitcnt vmcnt(18)
    s_bfe_u32 s40, s39, 0xd0007
    buffer_load_dwordx4 v[204:207], v2, s[24:27], s40 offen
    buffer_load_dwordx4 v[128:131], v1, s[20:23], s39 offen offset:1536 nt
    buffer_load_dwordx4 v[132:135], v1, s[20:23], s39 offen offset:1792 nt
    v_perm_b32 v11, v164, v160, s37
    v_perm_b32 v15, v164, v160, s38
    v_perm_b32 v19, v165, v161, s37
    v_perm_b32 v23, v165, v161, s38
    v_perm_b32 v27, v166, v162, s37
    v_perm_b32 v31, v166, v162, s38
    v_perm_b32 v35, v167, v163, s37
    v_perm_b32 v39, v167, v163, s38
    v_mfma_f32_16x16x32_bf16 v[40:43], v[208:211], v[8:11], v[40:43]
    v_mfma_f32_16x16x32_bf16 v[44:47], v[208:211], v[12:15], v[44:47]
    v_mfma_f32_16x16x32_bf16 v[48:51], v[208:211], v[16:19], v[48:51]
    v_mfma_f32_16x16x32_bf16 v[52:55], v[208:211], v[20:23], v[52:55]
    v_mfma_f32_16x16x32_bf16 v[56:59], v[208:211], v[24:27], v[56:59]
    v_mfma_f32_16x16x32_bf16 v[60:63], v[208:211], v[28:31], v[60:63]
    v_mfma_f32_16x16x32_bf16 v[64:67], v[208:211], v[32:35], v[64:67]
    v_mfma_f32_16x16x32_bf16 v[68:71], v[208:211], v[36:39], v[68:71]
    s_waitcnt vmcnt(18)
    s_xor_b32 s39, s39, 0x1800
    buffer_load_dwordx4 v[136:139], v1, s[20:23], s39 offen nt
    buffer_load_dwordx4 v[140:143], v1, s[20:23], s39 offen offset:256 nt
    v_perm_b32 v8, v172, v168, s37
    v_perm_b32 v12, v172, v168, s38
    v_perm_b32 v16, v173, v169, s37
    v_perm_b32 v20, v173, v169, s38
    v_perm_b32 v24, v174, v170, s37
    v_perm_b32 v28, v174, v170, s38
    v_perm_b32 v32, v175, v171, s37
    v_perm_b32 v36, v175, v171, s38
    s_waitcnt vmcnt(18)
    buffer_load_dwordx4 v[144:147], v1, s[20:23], s39 offen offset:512 nt
    buffer_load_dwordx4 v[148:151], v1, s[20:23], s39 offen offset:768 nt
    v_perm_b32 v9, v180, v176, s37
    v_perm_b32 v13, v180, v176, s38
    v_perm_b32 v17, v181, v177, s37
    v_perm_b32 v21, v181, v177, s38
    v_perm_b32 v25, v182, v178, s37
    v_perm_b32 v29, v182, v178, s38
    v_perm_b32 v33, v183, v179, s37
    v_perm_b32 v37, v183, v179, s38
    ds_read_b32 v217, v216 offset:8704
    s_waitcnt vmcnt(18)
    buffer_load_dwordx4 v[152:155], v1, s[20:23], s39 offen offset:1024 nt
    buffer_load_dwordx4 v[156:159], v1, s[20:23], s39 offen offset:1280 nt
    v_perm_b32 v10, v188, v184, s37
    v_perm_b32 v14, v188, v184, s38
    v_perm_b32 v18, v189, v185, s37
    v_perm_b32 v22, v189, v185, s38
    v_perm_b32 v26, v190, v186, s37
    v_perm_b32 v30, v190, v186, s38
    v_perm_b32 v34, v191, v187, s37
    v_perm_b32 v38, v191, v187, s38
    s_waitcnt vmcnt(18)
    s_bfe_u32 s40, s39, 0xd0007
    buffer_load_dwordx4 v[208:211], v2, s[24:27], s40 offen
    buffer_load_dwordx4 v[160:163], v1, s[20:23], s39 offen offset:1536 nt
    buffer_load_dwordx4 v[164:167], v1, s[20:23], s39 offen offset:1792 nt
    v_perm_b32 v11, v196, v192, s37
    v_perm_b32 v15, v196, v192, s38
    v_perm_b32 v19, v197, v193, s37
    v_perm_b32 v23, v197, v193, s38
    v_perm_b32 v27, v198, v194, s37
    v_perm_b32 v31, v198, v194, s38
    v_perm_b32 v35, v199, v195, s37
    v_perm_b32 v39, v199, v195, s38
    s_waitcnt lgkmcnt(0)
    v_readfirstlane_b32 s49, v217
    v_mfma_f32_16x16x32_bf16 v[40:43], v[212:215], v[8:11], v[40:43]
    v_mfma_f32_16x16x32_bf16 v[44:47], v[212:215], v[12:15], v[44:47]
    v_mfma_f32_16x16x32_bf16 v[48:51], v[212:215], v[16:19], v[48:51]
    v_mfma_f32_16x16x32_bf16 v[52:55], v[212:215], v[20:23], v[52:55]
    v_mfma_f32_16x16x32_bf16 v[56:59], v[212:215], v[24:27], v[56:59]
    v_mfma_f32_16x16x32_bf16 v[60:63], v[212:215], v[28:31], v[60:63]
    v_mfma_f32_16x16x32_bf16 v[64:67], v[212:215], v[32:35], v[64:67]
    v_mfma_f32_16x16x32_bf16 v[68:71], v[212:215], v[36:39], v[68:71]
    s_branch L_next
L_last:
    ds_read_b64 v[216:217], v4 offset:8192
    s_waitcnt vmcnt(25)
    s_xor_b32 s39, s39, 0x800
    buffer_load_dwordx4 v[168:171], v1, s[20:23], s39 offen nt
    buffer_load_dwordx4 v[172:175], v1, s[20:23], s39 offen offset:256 nt
    v_perm_b32 v220, v76, v72, s37
    v_perm_b32 v224, v76, v72, s38
    v_perm_b32 v228, v77, v73, s37
    v_perm_b32 v232, v77, v73, s38
    v_perm_b32 v236, v78, v74, s37
    v_perm_b32 v240, v78, v74, s38
    v_perm_b32 v244, v79, v75, s37
    v_perm_b32 v248, v79, v75, s38
    s_waitcnt vmcnt(25)
    buffer_load_dwordx4 v[176:179], v1, s[20:23], s39 offen offset:512 nt
    buffer_load_dwordx4 v[180:183], v1, s[20:23], s39 offen offset:768 nt
    v_perm_b32 v221, v84, v80, s37
    v_perm_b32 v225, v84, v80, s38
    v_perm_b32 v229, v85, v81, s37
    v_perm_b32 v233, v85, v81, s38
    v_perm_b32 v237, v86, v82, s37
    v_perm_b32 v241, v86, v82, s38
    v_perm_b32 v245, v87, v83, s37
    v_perm_b32 v249, v87, v83, s38
    s_waitcnt vmcnt(25)
    buffer_load_dwordx4 v[184:187], v1, s[20:23], s39 offen offset:1024 nt
    buffer_load_dwordx4 v[188:191], v1, s[20:23], s39 offen offset:1280 nt
    v_perm_b32 v222, v92, v88, s37
    v_perm_b32 v226, v92, v88, s38
    v_perm_b32 v230, v93, v89, s37
    v_perm_b32 v234, v93, v89, s38
    v_perm_b32 v238, v94, v90, s37
    v_perm_b32 v242, v94, v90, s38
    v_perm_b32 v246, v95, v91, s37
    v_perm_b32 v250, v95, v91, s38
    s_waitcnt vmcnt(24)
    s_bfe_u32 s40, s39, 0xd0007
    buffer_load_dwordx4 v[212:215], v2, s[24:27], s40 offen
    buffer_load_dwordx4 v[192:195], v1, s[20:23], s39 offen offset:1536 nt
    buffer_load_dwordx4 v[196:199], v1, s[20:23], s39 offen offset:1792 nt
    v_perm_b32 v223, v100, v96, s37
    v_perm_b32 v227, v100, v96, s38
    v_perm_b32 v231, v101, v97, s37
    v_perm_b32 v235, v101, v97, s38
    v_perm_b32 v239, v102, v98, s37
    v_perm_b32 v243, v102, v98, s38
    v_perm_b32 v247, v103, v99, s37
    v_perm_b32 v251, v103, v99, s38
    s_waitcnt vmcnt(25)
    v_perm_b32 v8, v108, v104, s37
    v_mfma_f32_16x16x32_bf16 v[40:43], v[200:203], v[220:223], v[40:43]
    v_perm_b32 v12, v108, v104, s38
    v_perm_b32 v16, v109, v105, s37
    v_perm_b32 v20, v109, v105, s38
    v_mfma_f32_16x16x32_bf16 v[44:47], v[200:203], v[224:227], v[44:47]
    v_perm_b32 v24, v110, v106, s37
    v_perm_b32 v28, v110, v106, s38
    v_perm_b32 v32, v111, v107, s37
    v_mfma_f32_16x16x32_bf16 v[48:51], v[200:203], v[228:231], v[48:51]
    v_perm_b32 v36, v111, v107, s38
    s_waitcnt vmcnt(23)
    v_perm_b32 v9, v116, v112, s37
    v_mfma_f32_16x16x32_bf16 v[52:55], v[200:203], v[232:235], v[52:55]
    v_perm_b32 v13, v116, v112, s38
    v_perm_b32 v17, v117, v113, s37
    v_perm_b32 v21, v117, v113, s38
    v_mfma_f32_16x16x32_bf16 v[56:59], v[200:203], v[236:239], v[56:59]
    v_perm_b32 v25, v118, v114, s37
    v_perm_b32 v29, v118, v114, s38
    v_perm_b32 v33, v119, v115, s37
    v_mfma_f32_16x16x32_bf16 v[60:63], v[200:203], v[240:243], v[60:63]
    v_perm_b32 v37, v119, v115, s38
    s_waitcnt vmcnt(21)
    v_perm_b32 v10, v124, v120, s37
    v_mfma_f32_16x16x32_bf16 v[64:67], v[200:203], v[244:247], v[64:67]
    v_perm_b32 v14, v124, v120, s38
    v_perm_b32 v18, v125, v121, s37
    v_perm_b32 v22, v125, v121, s38
    v_mfma_f32_16x16x32_bf16 v[68:71], v[200:203], v[248:251], v[68:71]
    v_perm_b32 v26, v126, v122, s37
    v_perm_b32 v30, v126, v122, s38
    v_perm_b32 v34, v127, v123, s37
    v_perm_b32 v38, v127, v123, s38
    s_waitcnt vmcnt(18)
    v_perm_b32 v11, v132, v128, s37
    v_perm_b32 v15, v132, v128, s38
    v_perm_b32 v19, v133, v129, s37
    v_perm_b32 v23, v133, v129, s38
    v_perm_b32 v27, v134, v130, s37
    v_perm_b32 v31, v134, v130, s38
    v_perm_b32 v35, v135, v131, s37
    v_perm_b32 v39, v135, v131, s38
    s_waitcnt vmcnt(16) lgkmcnt(0)
    v_perm_b32 v220, v140, v136, s37
    v_mfma_f32_16x16x32_bf16 v[40:43], v[204:207], v[8:11], v[40:43]
    v_perm_b32 v224, v140, v136, s38
    v_perm_b32 v228, v141, v137, s37
    v_perm_b32 v232, v141, v137, s38
    v_mfma_f32_16x16x32_bf16 v[44:47], v[204:207], v[12:15], v[44:47]
    v_perm_b32 v236, v142, v138, s37
    v_perm_b32 v240, v142, v138, s38
    v_perm_b32 v244, v143, v139, s37
    v_mfma_f32_16x16x32_bf16 v[48:51], v[204:207], v[16:19], v[48:51]
    v_perm_b32 v248, v143, v139, s38
    s_waitcnt vmcnt(14)
    v_perm_b32 v221, v148, v144, s37
    v_mfma_f32_16x16x32_bf16 v[52:55], v[204:207], v[20:23], v[52:55]
    v_perm_b32 v225, v148, v144, s38
    v_perm_b32 v229, v149, v145, s37
    v_perm_b32 v233, v149, v145, s38
    v_mfma_f32_16x16x32_bf16 v[56:59], v[204:207], v[24:27], v[56:59]
    v_perm_b32 v237, v150, v146, s37
    v_perm_b32 v241, v150, v146, s38
    v_perm_b32 v245, v151, v147, s37
    v_mfma_f32_16x16x32_bf16 v[60:63], v[204:207], v[28:31], v[60:63]
    v_perm_b32 v249, v151, v147, s38
    s_waitcnt vmcnt(12)
    v_perm_b32 v222, v156, v152, s37
    v_mfma_f32_16x16x32_bf16 v[64:67], v[204:207], v[32:35], v[64:67]
    v_perm_b32 v226, v156, v152, s38
    v_perm_b32 v230, v157, v153, s37
    v_perm_b32 v234, v157, v153, s38
    v_mfma_f32_16x16x32_bf16 v[68:71], v[204:207], v[36:39], v[68:71]
    v_perm_b32 v238, v158, v154, s37
    v_perm_b32 v242, v158, v154, s38
    v_perm_b32 v246, v159, v155, s37
    v_perm_b32 v250, v159, v155, s38
    s_waitcnt vmcnt(9)
    v_perm_b32 v223, v164, v160, s37
    v_perm_b32 v227, v164, v160, s38
    v_perm_b32 v231, v165, v161, s37
    v_perm_b32 v235, v165, v161, s38
    v_perm_b32 v239, v166, v162, s37
    v_perm_b32 v243, v166, v162, s38
    v_perm_b32 v247, v167, v163, s37
    v_perm_b32 v251, v167, v163, s38
    s_waitcnt vmcnt(7)
    v_perm_b32 v8, v172, v168, s37
    v_mfma_f32_16x16x32_bf16 v[40:43], v[208:211], v[220:223], v[40:43]
    v_perm_b32 v12, v172, v168, s38
    v_perm_b32 v16, v173, v169, s37
    v_perm_b32 v20, v173, v169, s38
    v_mfma_f32_16x16x32_bf16 v[44:47], v[208:211], v[224:227], v[44:47]
    v_perm_b32 v24, v174, v170, s37
    v_perm_b32 v28, v174, v170, s38
    v_perm_b32 v32, v175, v171, s37
    v_mfma_f32_16x16x32_bf16 v[48:51], v[208:211], v[228:231], v[48:51]
    v_perm_b32 v36, v175, v171, s38
    s_waitcnt vmcnt(5)
    v_perm_b32 v9, v180, v176, s37
    v_mfma_f32_16x16x32_bf16 v[52:55], v[208:211], v[232:235], v[52:55]
    v_perm_b32 v13, v180, v176, s38
    v_perm_b32 v17, v181, v177, s37
    v_perm_b32 v21, v181, v177, s38
    v_mfma_f32_16x16x32_bf16 v[56:59], v[208:211], v[236:239], v[56:59]
    v_perm_b32 v25, v182, v178, s37
    v_perm_b32 v29, v182, v178, s38
    v_perm_b32 v33, v183, v179, s37
    v_mfma_f32_16x16x32_bf16 v[60:63], v[208:211], v[240:243], v[60:63]
    v_perm_b32 v37, v183, v179, s38
    s_waitcnt vmcnt(3)
    v_perm_b32 v10, v188, v184, s37
    v_mfma_f32_16x16x32_bf16 v[64:67], v[208:211], v[244:247], v[64:67]
    v_perm_b32 v14, v188, v184, s38
    v_perm_b32 v18, v189, v185, s37
    v_perm_b32 v22, v189, v185, s38
    v_mfma_f32_16x16x32_bf16 v[68:71], v[208:211], v[248:251], v[68:71]
    v_perm_b32 v26, v190, v186, s37
    v_perm_b32 v30, v190, v186, s38
    v_perm_b32 v34, v191, v187, s37
    v_perm_b32 v38, v191, v187, s38
    s_waitcnt vmcnt(0)
    v_perm_b32 v11, v196, v192, s37
    v_perm_b32 v15, v196, v192, s38
    v_perm_b32 v19, v197, v193, s37
    v_mfma_f32_16x16x32_bf16 v[40:43], v[212:215], v[8:11], v[40:43]
    v_perm_b32 v23, v197, v193, s38
    v_perm_b32 v27, v198, v194, s37
    v_mfma_f32_16x16x32_bf16 v[44:47], v[212:215], v[12:15], v[44:47]
    v_perm_b32 v31, v198, v194, s38
    v_perm_b32 v35, v199, v195, s37
    v_mfma_f32_16x16x32_bf16 v[48:51], v[212:215], v[16:19], v[48:51]
    v_perm_b32 v39, v199, v195, s38
    v_mfma_f32_16x16x32_bf16 v[52:55], v[212:215], v[20:23], v[52:55]
    v_cvt_pk_bf16_f32 v220, v40, v41
    v_cvt_pk_bf16_f32 v221, v42, v43
    v_mfma_f32_16x16x32_bf16 v[56:59], v[212:215], v[24:27], v[56:59]
    v_cvt_pk_bf16_f32 v222, v44, v45
    v_cvt_pk_bf16_f32 v223, v46, v47
    v_mfma_f32_16x16x32_bf16 v[60:63], v[212:215], v[28:31], v[60:63]
    v_cvt_pk_bf16_f32 v224, v48, v49
    v_cvt_pk_bf16_f32 v225, v50, v51
    v_mfma_f32_16x16x32_bf16 v[64:67], v[212:215], v[32:35], v[64:67]
    v_cvt_pk_bf16_f32 v226, v52, v53
    v_cvt_pk_bf16_f32 v227, v54, v55
    v_mfma_f32_16x16x32_bf16 v[68:71], v[212:215], v[36:39], v[68:71]
    v_cvt_pk_bf16_f32 v228, v56, v57
    v_cvt_pk_bf16_f32 v229, v58, v59
    v_mfma_f32_16x16x16_bf16 v[40:43], v[216:217], v[220:221], 0
    v_cvt_pk_bf16_f32 v230, v60, v61
    v_cvt_pk_bf16_f32 v231, v62, v63
    v_mfma_f32_16x16x16_bf16 v[44:47], v[216:217], v[222:223], 0
    v_cvt_pk_bf16_f32 v232, v64, v65
    v_cvt_pk_bf16_f32 v233, v66, v67
    v_mfma_f32_16x16x16_bf16 v[48:51], v[216:217], v[224:225], 0
    v_cvt_pk_bf16_f32 v234, v68, v69
    v_cvt_pk_bf16_f32 v235, v70, v71
    v_mfma_f32_16x16x16_bf16 v[52:55], v[216:217], v[226:227], 0
    v_mfma_f32_16x16x16_bf16 v[56:59], v[216:217], v[228:229], 0
    v_mfma_f32_16x16x16_bf16 v[60:63], v[216:217], v[230:231], 0
    v_cvt_pk_bf16_f32 v236, v40, v44
    v_cvt_pk_bf16_f32 v240, v41, v45
    v_mfma_f32_16x16x16_bf16 v[64:67], v[216:217], v[232:233], 0
    v_cvt_pk_bf16_f32 v244, v42, v46
    v_cvt_pk_bf16_f32 v248, v43, v47
    v_mfma_f32_16x16x16_bf16 v[68:71], v[216:217], v[234:235], 0
    v_cvt_pk_bf16_f32 v237, v48, v52
    v_cvt_pk_bf16_f32 v241, v49, v53
    v_cvt_pk_bf16_f32 v245, v50, v54
    v_cvt_pk_bf16_f32 v249, v51, v55
    v_cvt_pk_bf16_f32 v238, v56, v60
    v_cvt_pk_bf16_f32 v242, v57, v61
    v_cvt_pk_bf16_f32 v246, v58, v62
    v_cvt_pk_bf16_f32 v250, v59, v63
    v_cvt_pk_bf16_f32 v239, v64, v68
    v_cvt_pk_bf16_f32 v243, v65, v69
    v_cvt_pk_bf16_f32 v247, v66, v70
    v_cvt_pk_bf16_f32 v251, v67, v71
    buffer_store_dwordx4 v[236:239], v5, s[32:35], 0 offen
    buffer_store_dwordx4 v[240:243], v5, s[32:35], 0 offen offset:256
    buffer_store_dwordx4 v[244:247], v5, s[32:35], 0 offen offset:512
    buffer_store_dwordx4 v[248:251], v5, s[32:35], 0 offen offset:768
L_end:
    s_endpgm
L_helper:
    v_mov_b32 v216, 0
    v_lshlrev_b32 v4, 3, v0
    s_lshl_b32 s48, s2, 11
    s_mov_b32 s49, 0xfc0
    s_lshl_b32 s62, s62, 12
    s_waitcnt vmcnt(0) lgkmcnt(0)
    s_load_dword s64, s[8:9], s43
    s_load_dword s64, s[12:13], 0
    s_load_dword s64, s[14:15], s48
    s_load_dword s64, s[18:19], s49
    s_mov_b32 s50, s62
    s_add_u32 s51, s50, 4096
L_fetch1:
    s_load_dword s64, s[12:13], s50 offset:0
    s_load_dword s64, s[12:13], s50 offset:64
    s_load_dword s64, s[12:13], s50 offset:128
    s_load_dword s64, s[12:13], s50 offset:192
    s_load_dword s64, s[12:13], s50 offset:256
    s_load_dword s64, s[12:13], s50 offset:320
    s_load_dword s64, s[12:13], s50 offset:384
    s_load_dword s64, s[12:13], s50 offset:448
    s_add_u32 s50, s50, 512
    s_cmp_lt_u32 s50, s51
    s_cbranch_scc1 L_fetch1
    s_mov_b32 s50, s48
    s_add_u32 s51, s50, 2048
L_fetch2:
    s_load_dword s64, s[4:5], s50 offset:0
    s_load_dword s64, s[4:5], s50 offset:64
    s_load_dword s64, s[4:5], s50 offset:128
    s_load_dword s64, s[4:5], s50 offset:192
    s_load_dword s64, s[4:5], s50 offset:256
    s_load_dword s64, s[4:5], s50 offset:320
    s_load_dword s64, s[4:5], s50 offset:384
    s_load_dword s64, s[4:5], s50 offset:448
    s_add_u32 s50, s50, 512
    s_cmp_lt_u32 s50, s51
    s_cbranch_scc1 L_fetch2
    s_add_u32 s24, s4, s48
    s_addc_u32 s25, s5, 0
    s_mov_b32 s26, 2048
    v_lshlrev_b32 v9, 8, v7
    v_lshl_add_u32 v9, v6, 6, v9
    v_mov_b32 v10, s43
    v_mov_b32 v11, s48
    s_waitcnt lgkmcnt(0)
    buffer_load_dwordx4 v[72:75], v9, s[24:27], 0 offen
    buffer_load_dwordx4 v[76:79], v9, s[24:27], 0 offen offset:16
    buffer_load_dwordx4 v[80:83], v9, s[24:27], 0 offen offset:32
    buffer_load_dwordx4 v[84:87], v9, s[24:27], 0 offen offset:48
    global_load_dword v16, v10, s[8:9]
    global_load_dword v16, v216, s[12:13]
    global_load_dword v16, v11, s[14:15]
    v_lshrrev_b32 v9, 2, v7
    v_lshlrev_b32 v9, 8, v9
    v_lshl_add_u32 v9, v6, 6, v9
    v_and_b32 v11, 3, v7
    v_lshl_add_u32 v9, v11, 2, v9
    s_mov_b32 s50, 7
    s_add_u32 s62, s18, 0x1000
    s_addc_u32 s63, s19, 0
    s_lshl_b32 s59, s2, 7
    v_mov_b32 v13, s59
    s_mov_b32 s31, 0
    s_mov_b32 s30, 0
    v_mov_b32 v18, 0
    s_mov_b32 s46, 0x40d4fdf4
    v_mov_b32 v20, 0x43d98000
L_meet:
    s_waitcnt lgkmcnt(0)
    s_barrier
    s_memrealtime s[28:29]
    s_waitcnt lgkmcnt(0)
    s_load_dword s76, s[62:63], -1024
    s_load_dword s77, s[62:63], -896
    s_load_dword s78, s[62:63], -768
    s_load_dword s79, s[62:63], -640
    s_load_dword s80, s[62:63], -512
    s_load_dword s81, s[62:63], -384
    s_load_dword s82, s[62:63], -256
    s_load_dword s83, s[62:63], -128
    s_cmp_ge_u32 s2, 8
    s_cbranch_scc1 L_noref
    v_mov_b32 v15, s28
    s_mov_b64 exec, 1
    global_store_dword v13, v15, s[62:63] sc1
    s_mov_b64 exec, -1
L_noref:
    s_add_u32 s62, s62, 1024
    s_addc_u32 s63, s63, 0
    s_sub_u32 s29, s28, s31
    s_sub_u32 s55, s29, s30
    s_mov_b32 s30, s29
    s_add_u32 s29, s31, 0x400
    s_mov_b32 s31, s28
    s_mov_b32 s54, 0
    s_waitcnt lgkmcnt(0)
    s_sub_u32 s76, s29, s76
    s_add_u32 s53, s76, 0x10000
    s_cmp_lt_u32 s76, 0x800
    s_cselect_b32 s53, s53, 0
    s_add_u32 s54, s54, s53
    s_sub_u32 s77, s29, s77
    s_add_u32 s53, s77, 0x10000
    s_cmp_lt_u32 s77, 0x800
    s_cselect_b32 s53, s53, 0
    s_add_u32 s54, s54, s53
    s_sub_u32 s78, s29, s78
    s_add_u32 s53, s78, 0x10000
    s_cmp_lt_u32 s78, 0x800
    s_cselect_b32 s53, s53, 0
    s_add_u32 s54, s54, s53
    s_sub_u32 s79, s29, s79
    s_add_u32 s53, s79, 0x10000
    s_cmp_lt_u32 s79, 0x800
    s_cselect_b32 s53, s53, 0
    s_add_u32 s54, s54, s53
    s_sub_u32 s80, s29, s80
    s_add_u32 s53, s80, 0x10000
    s_cmp_lt_u32 s80, 0x800
    s_cselect_b32 s53, s53, 0
    s_add_u32 s54, s54, s53
    s_sub_u32 s81, s29, s81
    s_add_u32 s53, s81, 0x10000
    s_cmp_lt_u32 s81, 0x800
    s_cselect_b32 s53, s53, 0
    s_add_u32 s54, s54, s53
    s_sub_u32 s82, s29, s82
    s_add_u32 s53, s82, 0x10000
    s_cmp_lt_u32 s82, 0x800
    s_cselect_b32 s53, s53, 0
    s_add_u32 s54, s54, s53
    s_sub_u32 s83, s29, s83
    s_add_u32 s53, s83, 0x10000
    s_cmp_lt_u32 s83, 0x800
    s_cselect_b32 s53, s53, 0
    s_add_u32 s54, s54, s53
    s_lshr_b32 s53, s54, 16
    s_cbranch_scc0 L_keep
    s_cmp_eq_u32 s50, 7
    s_cbranch_scc1 L_keep
    s_and_b32 s54, s54, 0xffff
    v_cvt_f32_u32 v14, s53
    v_cvt_f32_u32 v15, s54
    v_rcp_f32 v14, v14
    v_cvt_f32_i32 v19, s55
    v_mul_f32 v14, v14, v15
    v_add_f32 v14, 0xc4800000, v14
    v_sub_f32 v15, v14, v18
    v_add_f32 v15, v15, v19
    s_cmp_le_u32 s50, 9
    s_cselect_b32 s54, 0, 1.0
    v_mov_b32 v18, v14
    v_fma_f32 v14, v15, s54, v14
    v_fma_f32 v14, v14, s46, v20
    v_cvt_i32_f32 v14, v14
    v_max_i32 v14, 0, v14
    v_min_i32 v14, 768, v14
    ds_write_b32 v216, v14 offset:8704
L_keep:
    s_cmp_eq_u32 s50, 33
    s_cbranch_scc1 L_soft
L_back:
    s_add_u32 s50, s50, 2
    s_cmp_le_u32 s50, 61
    s_cbranch_scc1 L_meet
    s_endpgm
L_soft:
    ds_read_b32 v88, v9 offset:0
    ds_read_b32 v89, v9 offset:1024
    ds_read_b32 v90, v9 offset:2048
    ds_read_b32 v91, v9 offset:3072
    ds_read_b32 v92, v9 offset:4096
    ds_read_b32 v93, v9 offset:5120
    ds_read_b32 v94, v9 offset:6144
    ds_read_b32 v95, v9 offset:7168
    s_waitcnt lgkmcnt(0)
    ds_read_b32 v96, v9 offset:16
    ds_read_b32 v97, v9 offset:1040
    ds_read_b32 v98, v9 offset:2064
    ds_read_b32 v99, v9 offset:3088
    ds_read_b32 v100, v9 offset:4112
    ds_read_b32 v101, v9 offset:5136
    ds_read_b32 v102, v9 offset:6160
    ds_read_b32 v103, v9 offset:7184
    s_waitcnt lgkmcnt(0)
    ds_read_b32 v104, v9 offset:32
    ds_read_b32 v105, v9 offset:1056
    ds_read_b32 v106, v9 offset:2080
    ds_read_b32 v107, v9 offset:3104
    ds_read_b32 v108, v9 offset:4128
    ds_read_b32 v109, v9 offset:5152
    ds_read_b32 v110, v9 offset:6176
    ds_read_b32 v111, v9 offset:7200
    s_waitcnt lgkmcnt(0)
    ds_read_b32 v112, v9 offset:48
    ds_read_b32 v113, v9 offset:1072
    ds_read_b32 v114, v9 offset:2096
    ds_read_b32 v115, v9 offset:3120
    ds_read_b32 v116, v9 offset:4144
    ds_read_b32 v117, v9 offset:5168
    ds_read_b32 v118, v9 offset:6192
    ds_read_b32 v119, v9 offset:7216
    s_waitcnt lgkmcnt(0)
    s_waitcnt vmcnt(0)
    s_mov_b32 s56, 0x3db504f3
    s_mov_b32 s57, 0x3fb8aa3b
    s_mov_b32 s58, 0xffff0000
    v_cvt_pk_bf16_f32 v120, v88, v89
    v_cvt_pk_bf16_f32 v121, v90, v91
    v_cvt_pk_bf16_f32 v122, v92, v93
    v_cvt_pk_bf16_f32 v123, v94, v95
    v_cvt_pk_bf16_f32 v124, v96, v97
    v_cvt_pk_bf16_f32 v125, v98, v99
    v_cvt_pk_bf16_f32 v126, v100, v101
    v_cvt_pk_bf16_f32 v127, v102, v103
    v_cvt_pk_bf16_f32 v128, v104, v105
    v_cvt_pk_bf16_f32 v129, v106, v107
    v_cvt_pk_bf16_f32 v130, v108, v109
    v_cvt_pk_bf16_f32 v131, v110, v111
    v_cvt_pk_bf16_f32 v132, v112, v113
    v_cvt_pk_bf16_f32 v133, v114, v115
    v_cvt_pk_bf16_f32 v134, v116, v117
    v_cvt_pk_bf16_f32 v135, v118, v119
    s_nop 1
    v_mfma_f32_16x16x32_bf16 v[136:139], v[120:123], v[72:75], 0
    v_mfma_f32_16x16x32_bf16 v[136:139], v[124:127], v[76:79], v[136:139]
    v_mfma_f32_16x16x32_bf16 v[136:139], v[128:131], v[80:83], v[136:139]
    v_mfma_f32_16x16x32_bf16 v[136:139], v[132:135], v[84:87], v[136:139]
    s_nop 7
    v_cvt_pk_bf16_f32 v140, v136, v137
    v_cvt_pk_bf16_f32 v141, v138, v139
    v_lshlrev_b32 v136, 16, v140
    v_and_b32 v137, s58, v140
    v_lshlrev_b32 v138, 16, v141
    v_and_b32 v139, s58, v141
    v_mul_f32 v136, s56, v136
    v_mul_f32 v137, s56, v137
    v_mul_f32 v138, s56, v138
    v_mul_f32 v139, s56, v139
    v_cvt_pk_bf16_f32 v140, v136, v137
    v_cvt_pk_bf16_f32 v141, v138, v139
    v_lshlrev_b32 v136, 16, v140
    v_and_b32 v137, s58, v140
    v_lshlrev_b32 v138, 16, v141
    v_and_b32 v139, s58, v141
    v_max_f32 v140, v136, v137
    v_max3_f32 v140, v138, v139, v140
    v_mov_b32 v141, v140
    s_nop 1
    v_permlane16_swap_b32 v140, v141
    v_max_f32 v140, v140, v141
    v_mov_b32 v141, v140
    s_nop 1
    v_permlane32_swap_b32 v140, v141
    v_max_f32 v140, v140, v141
    v_sub_f32 v136, v136, v140
    v_sub_f32 v137, v137, v140
    v_sub_f32 v138, v138, v140
    v_sub_f32 v139, v139, v140
    v_mul_f32 v136, s57, v136
    v_mul_f32 v137, s57, v137
    v_mul_f32 v138, s57, v138
    v_mul_f32 v139, s57, v139
    v_exp_f32 v136, v136
    v_exp_f32 v137, v137
    v_exp_f32 v138, v138
    v_exp_f32 v139, v139
    s_nop 0
    v_add_f32 v140, v136, v137
    v_add_f32 v141, v138, v139
    v_add_f32 v140, v140, v141
    v_mov_b32 v141, v140
    s_nop 1
    v_permlane16_swap_b32 v140, v141
    v_add_f32 v140, v140, v141
    v_mov_b32 v141, v140
    s_nop 1
    v_permlane32_swap_b32 v140, v141
    v_add_f32 v140, v140, v141
    v_rcp_f32 v140, v140
    s_nop 0
    v_mul_f32 v136, v136, v140
    v_mul_f32 v137, v137, v140
    v_mul_f32 v138, v138, v140
    v_mul_f32 v139, v139, v140
    v_cvt_pk_bf16_f32 v142, v136, v137
    v_cvt_pk_bf16_f32 v143, v138, v139
    ds_write_b64 v4, v[142:143] offset:8192
    s_branch L_back
L_codeend:
.if (L_codeend - L_pc) < 11264
.error "code prefetch runs past the code"
.endif
.section .rodata,"a"
.p2align 6
.amdhsa_kernel standalone__low_rank_proj_linformer__sampling_kernel
  .amdhsa_next_free_vgpr 252
  .amdhsa_next_free_sgpr 88
  .amdhsa_accum_offset 252
  .amdhsa_group_segment_fixed_size 0
  .amdhsa_kernarg_size 64
  .amdhsa_user_sgpr_count 2
  .amdhsa_user_sgpr_kernarg_segment_ptr 1
  .amdhsa_system_sgpr_workgroup_id_x 1
  .amdhsa_float_denorm_mode_32 3
.end_amdhsa_kernel
```
